```python
import torch

def _softmax(x, axis=-1):
    return torch.softmax(x, dim=axis)
def _gelu(x):
    return torch.nn.functional.gelu(x, approximate="tanh")
def _silu(x):
    return torch.nn.functional.silu(x)
def _sigmoid(x):
    return torch.sigmoid(x)
def _layernorm(x, axis=-1, eps=1e-5):
    m = x.mean(dim=axis, keepdim=True)
    v = x.var(dim=axis, keepdim=True, unbiased=False)
    return (x - m) / torch.sqrt(v + eps)
def _scatter_add(tgt, idx, src, axis=0):
    return tgt.clone().index_add_(axis, idx, src)
def _segment_sum(src, seg, n):
    out = torch.zeros((n,) + src.shape[1:], dtype=src.dtype)
    return out.index_add_(0, seg, src)
def _pad(x, pw):
    flat = tuple(v for pair in reversed(pw) for v in pair)
    return torch.nn.functional.pad(x, flat)

kernel_name = 'standalone__edge_featured_mpnn_egc__graph'

def setup_inputs():

    _w = (lambda a: (lambda t: t.to(torch.bfloat16) if t.is_floating_point() else t)(torch.as_tensor(a)))
    N, deg, D, De = 50000, 16, 64, max(16, 1)
    E = N * deg
    return {
        "x": _w((lambda *s: torch.randn(*s, dtype=torch.bfloat16) * 0.2)(N, D)),
        "e_attr": _w((lambda *s: torch.randn(*s, dtype=torch.bfloat16) * 0.2)(E, De)),
        "src": _w((lambda lo, hi, *s: torch.randint(lo, hi, s))(0, N, E).to(torch.int64)),
        "dst": _w((lambda lo, hi, *s: torch.randint(lo, hi, s))(0, N, E).to(torch.int64)),
        "u_w": _w((lambda *s: torch.randn(*s, dtype=torch.bfloat16) * 0.05)(D, D)),
        "v_w": _w((lambda *s: torch.randn(*s, dtype=torch.bfloat16) * 0.05)(D, D)),
        "g_w": _w((lambda *s: torch.randn(*s, dtype=torch.bfloat16) * 0.2)(2 * D + De, D)),
    }

def reference(x, e_attr, src, dst, u_w, v_w, g_w):
    N, D = x.shape
    g_in = torch.concatenate([x[dst], x[src], e_attr], axis=-1)
    eta = _sigmoid(g_in @ g_w)
    hv = x @ v_w
    msg = eta * hv[src]
    agg = _segment_sum(msg, dst, N)
    return _silu(x @ u_w + agg)
```

```asm
; @launch kernel=egc_bin_kernel grid=(250,1,1) block=(1024,1,1) lds=26624
; @launch kernel=egc_main_kernel grid=(256,1,1) block=(512,1,1) lds=158912
.amdgcn_target "amdgcn-amd-amdhsa--gfx950"
.text
.globl egc_bin_kernel
.p2align 8
.type egc_bin_kernel,@function
egc_bin_kernel:
    s_cmp_ge_u32 s2, 250
    s_cbranch_scc1 L_k1_end
    s_load_dwordx4 s[4:7], s[0:1], 16
    s_load_dwordx4 s[8:11], s[0:1], 32
    s_load_dwordx2 s[12:13], s[0:1], 48
    s_load_dwordx2 s[14:15], s[0:1], 72
    v_and_b32 v1, 0xff, v0
    v_lshlrev_b32 v1, 2, v1
    v_mov_b32 v2, 0
    ds_write_b32 v1, v2 offset:0
    v_lshlrev_b32 v4, 4, v0
    v_lshrrev_b32 v5, 6, v0
    s_mul_i32 s32, s2, 12800
    v_readfirstlane_b32 s3, v5
    s_mov_b32 s33, 175921861
    s_movk_i32 s36, 3125
    s_mul_i32 s37, s2, 102400
    s_waitcnt lgkmcnt(0)
    s_mov_b32 s16, s4
    s_mov_b32 s17, s5
    s_mov_b32 s18, 3200000
    s_mov_b32 s19, 0x00020000
    s_mov_b32 s20, s6
    s_mov_b32 s21, s7
    s_mov_b32 s22, 3200000
    s_mov_b32 s23, 0x00020000
    s_mov_b32 s24, s14
    s_mov_b32 s25, s15
    s_mov_b32 s26, 16777216
    s_mov_b32 s27, 0x00020000
    v_cmp_gt_u32 vcc, 800, v0
    s_and_saveexec_b64 s[34:35], vcc
    s_cbranch_execz L_k1_noload
    buffer_load_dwordx4 v[8:11], v4, s[20:23], s32 offen
    buffer_load_dwordx4 v[12:15], v4, s[16:19], s32 offen
L_k1_noload:
    s_mov_b64 exec, s[34:35]
    s_cmp_lg_u32 s3, 13
    s_cbranch_scc1 L_k1_notlb
    s_load_dwordx4 s[52:55], s[0:1], 0
    s_load_dwordx2 s[56:57], s[0:1], 56
    s_lshr_b32 s62, s2, 3
    v_and_b32 v40, 63, v0
    s_mul_i32 s63, s62, 851968
    s_mul_i32 s62, s62, 262144
    s_mov_b32 s58, 65536
    v_mul_lo_u32 v41, v40, s58
    s_waitcnt lgkmcnt(0)
    s_mov_b32 s64, s54
    s_mov_b32 s65, s55
    s_mov_b32 s66, 25600000
    s_mov_b32 s67, 0x00020000
    s_bfm_b64 exec, 13, 0
    buffer_load_dword v42, v41, s[64:67], s63 offen
    s_mov_b32 s64, s52
    s_mov_b32 s65, s53
    s_mov_b32 s66, 6400000
    s_mov_b32 s67, 0x00020000
    s_bfm_b64 exec, 4, 0
    buffer_load_dword v43, v41, s[64:67], s62 offen
    s_mov_b32 s64, s56
    s_mov_b32 s65, s57
    s_mov_b32 s66, 6400000
    s_mov_b32 s67, 0x00020000
    buffer_load_dword v44, v41, s[64:67], s62 offen
    s_mov_b64 exec, -1
L_k1_notlb:
    s_mov_b32 s40, 0
    s_cmp_lg_u32 s3, 15
    s_cbranch_scc1 L_k1_nowf
    s_cmp_ge_u32 s2, 34
    s_cbranch_scc1 L_k1_nowf
    s_mov_b32 s40, 1
    s_mov_b32 s28, s12
    s_mov_b32 s29, s13
    s_mov_b32 s30, 18432
    s_mov_b32 s31, 0x00020000
    s_mov_b32 s41, s2
    s_cmp_lt_u32 s2, 18
    s_cbranch_scc1 L_k1_wsel
    s_mov_b32 s28, s10
    s_mov_b32 s29, s11
    s_mov_b32 s30, 8192
    s_sub_u32 s41, s2, 18
    s_cmp_lt_u32 s2, 26
    s_cbranch_scc1 L_k1_wsel
    s_mov_b32 s28, s8
    s_mov_b32 s29, s9
    s_sub_u32 s41, s2, 26
L_k1_wsel:
    s_lshr_b32 s42, s41, 1
    s_lshl_b32 s42, s42, 11
    s_and_b32 s43, s41, 1
    s_lshl_b32 s43, s43, 1
    s_add_u32 s42, s42, s43
    v_and_b32 v40, 31, v0
    v_lshlrev_b32 v40, 2, v40
    v_and_b32 v41, 32, v0
    v_lshl_add_u32 v40, v41, 5, v40
    buffer_load_ushort v44, v40, s[28:31], s42 offen offset:0
    buffer_load_ushort v45, v40, s[28:31], s42 offen offset:128
    buffer_load_ushort v46, v40, s[28:31], s42 offen offset:256
    buffer_load_ushort v47, v40, s[28:31], s42 offen offset:384
    buffer_load_ushort v48, v40, s[28:31], s42 offen offset:512
    buffer_load_ushort v49, v40, s[28:31], s42 offen offset:640
    buffer_load_ushort v50, v40, s[28:31], s42 offen offset:768
    buffer_load_ushort v51, v40, s[28:31], s42 offen offset:896
L_k1_nowf:
    s_barrier
    s_and_saveexec_b64 s[34:35], vcc
    s_cbranch_execz L_k1_nohist
    v_mov_b32 v6, 1
    v_mov_b32 v5, 0x7f
    v_lshl_add_u32 v7, v0, 7, s37
    s_waitcnt vmcnt(1)
    v_mul_hi_u32 v16, v8, s33
    v_mul_hi_u32 v17, v9, s33
    v_mul_hi_u32 v18, v10, s33
    v_mul_hi_u32 v19, v11, s33
    v_lshrrev_b32 v20, 3, v16
    v_lshrrev_b32 v21, 3, v17
    v_lshrrev_b32 v22, 3, v18
    v_lshrrev_b32 v23, 3, v19
    v_lshlrev_b32 v20, 2, v20
    v_lshlrev_b32 v21, 2, v21
    v_lshlrev_b32 v22, 2, v22
    v_lshlrev_b32 v23, 2, v23
    ds_add_rtn_u32 v24, v20, v6 offset:0
    ds_add_rtn_u32 v25, v21, v6 offset:0
    ds_add_rtn_u32 v26, v22, v6 offset:0
    ds_add_rtn_u32 v27, v23, v6 offset:0
    v_mad_u32_u24 v28, v16, s36, v5
    v_mad_u32_u24 v29, v17, s36, v5
    v_mad_u32_u24 v30, v18, s36, v5
    v_mad_u32_u24 v31, v19, s36, v5
    v_lshrrev_b32 v28, 7, v28
    v_lshrrev_b32 v29, 7, v29
    v_lshrrev_b32 v30, 7, v30
    v_lshrrev_b32 v31, 7, v31
    v_sub_u32 v28, v8, v28
    v_sub_u32 v29, v9, v29
    v_sub_u32 v30, v10, v30
    v_sub_u32 v31, v11, v31
    v_lshlrev_b32 v16, 29, v16
    v_lshlrev_b32 v17, 29, v17
    v_lshlrev_b32 v18, 29, v18
    v_lshlrev_b32 v19, 29, v19
    v_or3_b32 v33, v16, v7, v28
    v_or3_b32 v35, v17, v7, v29
    v_or3_b32 v37, v18, v7, v30
    v_or3_b32 v39, v19, v7, v31
    v_add_u32 v35, 32, v35
    v_add_u32 v37, 64, v37
    v_add_u32 v39, 96, v39
    s_waitcnt vmcnt(0)
    v_lshlrev_b32 v32, 7, v12
    v_lshlrev_b32 v34, 7, v13
    v_lshlrev_b32 v36, 7, v14
    v_lshlrev_b32 v38, 7, v15
    v_mul_u32_u24 v12, 0x53e, v12
    v_mul_u32_u24 v13, 0x53e, v13
    v_mul_u32_u24 v14, 0x53e, v14
    v_mul_u32_u24 v15, 0x53e, v15
    v_bfe_u32 v12, v12, 23, 3
    v_bfe_u32 v13, v13, 23, 3
    v_bfe_u32 v14, v14, 23, 3
    v_bfe_u32 v15, v15, 23, 3
    v_lshrrev_b32 v8, 7, v20
    v_lshrrev_b32 v9, 7, v21
    v_lshrrev_b32 v10, 7, v22
    v_lshrrev_b32 v11, 7, v23
    v_sub_u32 v12, v12, v8
    v_sub_u32 v13, v13, v9
    v_sub_u32 v14, v14, v10
    v_sub_u32 v15, v15, v11
    v_and_b32 v12, 7, v12
    v_and_b32 v13, 7, v13
    v_and_b32 v14, 7, v14
    v_and_b32 v15, 7, v15
    v_lshl_or_b32 v33, v12, 26, v33
    v_lshl_or_b32 v35, v13, 26, v35
    v_lshl_or_b32 v37, v14, 26, v37
    v_lshl_or_b32 v39, v15, 26, v39
L_k1_nohist:
    s_mov_b64 exec, s[34:35]
    s_waitcnt lgkmcnt(0)
    s_barrier
    s_cmp_lg_u32 s3, 14
    s_cbranch_scc1 L_k1_noscan
    v_and_b32 v1, 63, v0
    v_lshlrev_b32 v2, 4, v1
    ds_read_b128 v[8:11], v2 offset:0
    v_lshrrev_b32 v3, 2, v1
    v_lshlrev_b32 v3, 14, v3
    v_and_b32 v1, 3, v1
    v_lshl_add_u32 v3, v1, 4, v3
    s_lshl_b32 s46, s2, 6
    s_add_u32 s46, s46, 65536
    s_waitcnt lgkmcnt(0)
    v_add_u32 v12, v8, v9
    v_add_u32 v13, v12, v10
    v_add_u32 v14, v13, v11
    v_mov_b32 v15, v14
    s_nop 1
    v_add_u32_dpp v15, v15, v15 row_shr:1 row_mask:0xf bank_mask:0xf
    s_nop 1
    v_add_u32_dpp v15, v15, v15 row_shr:2 row_mask:0xf bank_mask:0xf
    s_nop 1
    v_add_u32_dpp v15, v15, v15 row_shr:4 row_mask:0xf bank_mask:0xf
    s_nop 1
    v_add_u32_dpp v15, v15, v15 row_shr:8 row_mask:0xf bank_mask:0xf
    s_nop 1
    v_add_u32_dpp v15, v15, v15 row_bcast:15 row_mask:0xa bank_mask:0xf
    s_nop 1
    v_add_u32_dpp v15, v15, v15 row_bcast:31 row_mask:0xc bank_mask:0xf
    v_sub_u32 v16, v15, v14
    v_add_u32 v17, v16, v8
    v_add_u32 v18, v16, v12
    v_add_u32 v19, v16, v13
    ds_write_b128 v2, v[16:19] offset:0
    v_lshl_or_b32 v8, v17, 16, v16
    v_lshl_or_b32 v9, v18, 16, v17
    v_lshl_or_b32 v10, v19, 16, v18
    v_lshl_or_b32 v11, v15, 16, v19
    buffer_store_dwordx4 v[8:11], v3, s[24:27], s46 offen sc1
    s_waitcnt lgkmcnt(0)
L_k1_noscan:
    s_barrier
    s_and_saveexec_b64 s[34:35], vcc
    s_cbranch_execz L_k1_noscat
    ds_read_b32 v28, v20 offset:0
    ds_read_b32 v29, v21 offset:0
    ds_read_b32 v30, v22 offset:0
    ds_read_b32 v31, v23 offset:0
    s_waitcnt lgkmcnt(3)
    v_add_lshl_u32 v28, v28, v24, 3
    s_waitcnt lgkmcnt(2)
    v_add_lshl_u32 v29, v29, v25, 3
    s_waitcnt lgkmcnt(1)
    v_add_lshl_u32 v30, v30, v26, 3
    s_waitcnt lgkmcnt(0)
    v_add_lshl_u32 v31, v31, v27, 3
    ds_write_b64 v28, v[32:33] offset:1024
    ds_write_b64 v29, v[34:35] offset:1024
    ds_write_b64 v30, v[36:37] offset:1024
    ds_write_b64 v31, v[38:39] offset:1024
L_k1_noscat:
    s_mov_b64 exec, s[34:35]
    s_waitcnt lgkmcnt(0)
    s_barrier
    s_mul_i32 s46, s2, 25600
    s_add_u32 s46, s46, 4194304
    ds_read_b128 v[16:19], v4 offset:1024
    s_cmp_ge_u32 s3, 9
    s_cbranch_scc1 L_k1_no2
    ds_read_b128 v[12:15], v4 offset:17408
    s_add_u32 s47, s46, 16384
    s_waitcnt lgkmcnt(0)
    buffer_store_dwordx4 v[12:15], v4, s[24:27], s47 offen sc1
L_k1_no2:
    s_waitcnt lgkmcnt(0)
    buffer_store_dwordx4 v[16:19], v4, s[24:27], s46 offen sc1
    s_cmp_eq_u32 s40, 0
    s_cbranch_scc1 L_k1_end
    s_waitcnt vmcnt(0)
    s_sub_u32 s46, s2, 8
    s_cmp_lt_u32 s46, 10
    s_cselect_b32 s47, 3216550459, 1.0
    v_lshlrev_b32 v44, 16, v44
    v_lshlrev_b32 v45, 16, v45
    v_lshlrev_b32 v46, 16, v46
    v_lshlrev_b32 v47, 16, v47
    v_lshlrev_b32 v48, 16, v48
    v_lshlrev_b32 v49, 16, v49
    v_lshlrev_b32 v50, 16, v50
    v_lshlrev_b32 v51, 16, v51
    v_mul_f32 v44, s47, v44
    v_mul_f32 v45, s47, v45
    v_mul_f32 v46, s47, v46
    v_mul_f32 v47, s47, v47
    v_mul_f32 v48, s47, v48
    v_mul_f32 v49, s47, v49
    v_mul_f32 v50, s47, v50
    v_mul_f32 v51, s47, v51
    v_cvt_pk_bf16_f32 v52, v44, v45
    v_cvt_pk_bf16_f32 v53, v46, v47
    v_cvt_pk_bf16_f32 v54, v48, v49
    v_cvt_pk_bf16_f32 v55, v50, v51
    v_and_b32 v40, 63, v0
    v_lshlrev_b32 v40, 4, v40
    s_lshl_b32 s46, s2, 10
    buffer_store_dwordx4 v[52:55], v40, s[24:27], s46 offen sc1
L_k1_end:
    s_endpgm
.globl egc_main_kernel
.p2align 8
.type egc_main_kernel,@function
egc_main_kernel:
    s_cmp_ge_u32 s2, 256
    s_cbranch_scc1 L_k2_end
    s_load_dwordx2 s[10:11], s[0:1], 72
    s_load_dwordx4 s[4:7], s[0:1], 0
    s_load_dwordx2 s[8:9], s[0:1], 56
    s_and_b32 s38, s2, 7
    s_lshr_b32 s39, s2, 3
    s_lshl_b32 s32, s38, 5
    s_add_u32 s32, s32, s39
    v_lshrrev_b32 v1, 6, v0
    v_and_b32 v67, 63, v0
    v_readfirstlane_b32 s3, v1
    s_mov_b32 s33, 0
    s_movk_i32 s34, 250
    s_mov_b32 s45, 0
    s_mov_b32 s47, 1
    s_lshr_b32 s48, s32, 4
    s_lshl_b32 s48, s48, 14
    s_and_b32 s46, s32, 15
    s_lshl_b32 s46, s46, 2
    s_add_u32 s48, s48, s46
    s_add_u32 s48, s48, 65536
    s_waitcnt lgkmcnt(0)
    s_add_u32 s20, s10, s48
    s_addc_u32 s21, s11, 0
    s_mov_b32 s22, 15940
    s_mov_b32 s23, 0x00020000
L_round:
    s_lshl_b32 s46, s3, 5
    v_lshrrev_b32 v66, 1, v67
    v_add_u32 v66, s46, v66
    v_lshlrev_b32 v65, 6, v66
    buffer_load_dword v48, v65, s[20:23], 0 offen
    v_lshlrev_b32 v69, 2, v67
    v_mov_b32 v49, 0
    ds_write2st64_b32 v69, v49, v49 offset0:136 offset1:137
    s_lshl_b32 s59, s3, 8
    v_add_u32 v87, s59, v69
    ds_write2st64_b32 v87, v49, v49 offset0:138 offset1:146
    s_cmp_eq_u32 s47, 0
    s_cbranch_scc1 L_tw0
    s_add_u32 s24, s10, 4194304
    s_addc_u32 s25, s11, 0
    s_mov_b32 s26, 6400000
    s_mov_b32 s27, 0x00020000
    s_mov_b32 s28, s10
    s_mov_b32 s29, s11
    s_mov_b32 s30, 34816
    s_mov_b32 s31, 0x00020000
    v_lshlrev_b32 v70, 4, v67
    s_add_u32 s46, s3, 0
    s_lshl_b32 s46, s46, 10
    s_add_u32 m0, s46, 39424
    s_nop 0
    buffer_load_dwordx4 v70, s[28:31], s46 offen lds
    s_add_u32 s46, s3, 8
    s_lshl_b32 s46, s46, 10
    s_add_u32 m0, s46, 39424
    s_nop 0
    buffer_load_dwordx4 v70, s[28:31], s46 offen lds
    s_add_u32 s46, s3, 16
    s_lshl_b32 s46, s46, 10
    s_add_u32 m0, s46, 39424
    s_nop 0
    buffer_load_dwordx4 v70, s[28:31], s46 offen lds
    s_add_u32 s46, s3, 24
    s_lshl_b32 s46, s46, 10
    s_add_u32 m0, s46, 39424
    s_nop 0
    buffer_load_dwordx4 v70, s[28:31], s46 offen lds
    s_add_u32 s46, s3, 32
    s_min_u32 s46, s46, 33
    s_lshl_b32 s46, s46, 10
    s_add_u32 m0, s46, 39424
    s_nop 0
    buffer_load_dwordx4 v70, s[28:31], s46 offen lds
    s_mov_b32 s12, s4
    s_mov_b32 s13, s5
    s_mov_b32 s14, 6400000
    s_mov_b32 s15, 0x00020000
    s_mov_b32 s16, s6
    s_mov_b32 s17, s7
    s_mov_b32 s18, 25600000
    s_mov_b32 s19, 0x00020000
    s_mov_b32 s40, 33554400
    s_movk_i32 s42, 80
    s_mov_b32 s43, 3216550459
    s_lshl_b32 s37, s3, 13
    s_add_u32 s37, s37, 93376
    v_and_b32 v3, 31, v67
    v_lshrrev_b32 v4, 5, v67
    v_bfe_u32 v5, v3, 1, 3
    v_xor_b32 v5, v5, v4
    v_lshlrev_b32 v5, 4, v5
    v_lshl_add_u32 v5, v3, 7, v5
    v_add_u32 v112, s37, v5
    v_xor_b32 v6, 32, v5
    v_add_u32 v113, s37, v6
    v_xor_b32 v6, 64, v5
    v_add_u32 v114, s37, v6
    v_xor_b32 v6, 96, v5
    v_add_u32 v115, s37, v6
    v_lshrrev_b32 v5, 4, v67
    v_and_b32 v6, 7, v67
    v_xor_b32 v5, v5, v6
    v_lshlrev_b32 v116, 4, v5
    v_lshlrev_b32 v117, 4, v4
    s_mul_i32 s46, s3, 2000
    s_add_u32 s46, s46, 74240
    v_lshrrev_b32 v5, 4, v3
    v_lshlrev_b32 v5, 5, v5
    v_bfe_u32 v6, v3, 2, 1
    v_lshl_add_u32 v5, v6, 4, v5
    v_bfe_u32 v6, v3, 3, 1
    v_lshl_add_u32 v5, v6, 3, v5
    v_and_b32 v6, 3, v3
    v_lshl_add_u32 v5, v6, 1, v5
    v_add_u32 v120, s46, v5
    v_add_u32 v6, s46, v117
    v_mad_u32_u24 v121, v3, s42, v6
    v_lshlrev_b32 v6, 5, v4
    v_add_u32 v122, 90816, v6
    v_mov_b32 v124, 1.0
    v_mov_b32 v8, 0
    v_mov_b32 v9, 0
    v_mov_b32 v10, 0
    v_mov_b32 v11, 0
    v_add_u32 v7, s46, v70
    ds_write_b128 v7, v[8:11]
    v_cmp_gt_u32 vcc, 61, v67
    s_and_saveexec_b64 s[50:51], vcc
    ds_write_b128 v7, v[8:11] offset:1024
    s_mov_b64 exec, -1
    v_add_u32 v70, 39424, v70
    s_cmp_lg_u32 s3, 0
    s_cbranch_scc1 L_noconst
    v_add_u32 v7, 51392, v70
    ds_write_b128 v7, v[8:11]
    ds_write_b128 v7, v[8:11] offset:1024
    s_mov_b32 exec_hi, 0
    ds_write_b128 v7, v[8:11] offset:2048
    v_bfe_u32 v6, v3, 2, 1
    v_lshlrev_b32 v6, 5, v6
    v_lshrrev_b32 v7, 4, v3
    v_lshl_add_u32 v6, v7, 4, v6
    v_and_b32 v7, 15, v5
    v_add_u32 v6, v6, v7
    v_mad_u32_u24 v6, v3, s42, v6
    v_add_u32 v6, 90816, v6
    ds_write_b16_d16_hi v6, v124
    s_mov_b64 exec, -1
L_noconst:
    s_waitcnt vmcnt(5)
    s_branch L_tw1
L_tw0:
    s_waitcnt vmcnt(0)
L_tw1:
    v_and_b32 v53, 0xffff, v48
    v_lshrrev_b32 v52, 16, v48
    v_subrev_u32 v54, s33, v66
    s_sub_u32 s46, s34, s33
    v_cmp_gt_u32 vcc, s46, v54
    v_and_b32 v55, 1, v67
    v_lshl_add_u32 v64, v55, 1, v53
    v_cndmask_b32 v54, v53, v52, vcc
    v_add_u32 v64, s45, v64
    s_movk_i32 s46, 25600
    v_mul_u32_u24 v65, s46, v66
    v_lshl_add_u32 v65, v64, 3, v65
    v_sub_u32 v68, v54, v64
    v_cmpx_lt_i32 vcc, 0, v68
    s_nop 0
    s_cbranch_execz L_rl
    buffer_load_dwordx4 v[0:3], v65, s[24:27], 0 offen offset:0
    v_cmpx_lt_i32 vcc, 4, v68
    s_nop 0
    s_cbranch_execz L_rl
    buffer_load_dwordx4 v[4:7], v65, s[24:27], 0 offen offset:32
    v_cmpx_lt_i32 vcc, 8, v68
    s_nop 0
    s_cbranch_execz L_rl
    buffer_load_dwordx4 v[8:11], v65, s[24:27], 0 offen offset:64
    v_cmpx_lt_i32 vcc, 12, v68
    s_nop 0
    s_cbranch_execz L_rl
    buffer_load_dwordx4 v[12:15], v65, s[24:27], 0 offen offset:96
    v_cmpx_lt_i32 vcc, 16, v68
    s_nop 0
    s_cbranch_execz L_rl
    buffer_load_dwordx4 v[16:19], v65, s[24:27], 0 offen offset:128
    v_cmpx_lt_i32 vcc, 20, v68
    s_nop 0
    s_cbranch_execz L_rl
    buffer_load_dwordx4 v[20:23], v65, s[24:27], 0 offen offset:160
    v_cmpx_lt_i32 vcc, 24, v68
    s_nop 0
    s_cbranch_execz L_rl
    buffer_load_dwordx4 v[24:27], v65, s[24:27], 0 offen offset:192
    v_cmpx_lt_i32 vcc, 28, v68
    s_nop 0
    s_cbranch_execz L_rl
    buffer_load_dwordx4 v[28:31], v65, s[24:27], 0 offen offset:224
L_rl:
    s_mov_b64 exec, -1
    v_mov_b32 v71, 1
    v_mov_b32 v72, 0x100
    s_waitcnt lgkmcnt(0)
    s_barrier
    s_waitcnt vmcnt(0)
    s_lshl_b32 s46, s32, 3
    s_add_u32 s46, s46, s3
    s_mul_i32 s46, s46, 3125
    s_add_u32 s46, s46, 127
    s_lshr_b32 s46, s46, 7
    s_lshl_b32 s46, s46, 7
    v_lshlrev_b32 v89, 7, v67
    s_bfm_b64 exec, 25, 0
    buffer_load_dword v126, v89, s[12:15], s46 offen
    s_mov_b64 exec, -1
    v_bfe_u32 v89, v1, 26, 3
    v_cmp_gt_u32 vcc, 1, v89
    v_cmp_lt_i32 s[50:51], 0, v68
    v_and_b32 v90, s40, v1
    s_and_b64 exec, vcc, s[50:51]
    s_cbranch_execz L_pf_0
    buffer_load_dword v127, v90, s[16:19], 0 offen
L_pf_0:
    s_mov_b64 exec, -1
    v_bfe_u32 v89, v3, 26, 3
    v_cmp_gt_u32 vcc, 1, v89
    v_cmp_lt_i32 s[50:51], 1, v68
    v_and_b32 v90, s40, v3
    s_and_b64 exec, vcc, s[50:51]
    s_cbranch_execz L_pf_1
    buffer_load_dword v127, v90, s[16:19], 0 offen
L_pf_1:
    s_mov_b64 exec, -1
    v_bfe_u32 v89, v5, 26, 3
    v_cmp_gt_u32 vcc, 1, v89
    v_cmp_lt_i32 s[50:51], 4, v68
    v_and_b32 v90, s40, v5
    s_and_b64 exec, vcc, s[50:51]
    s_cbranch_execz L_pf_2
    buffer_load_dword v127, v90, s[16:19], 0 offen
L_pf_2:
    s_mov_b64 exec, -1
    v_bfe_u32 v89, v7, 26, 3
    v_cmp_gt_u32 vcc, 1, v89
    v_cmp_lt_i32 s[50:51], 5, v68
    v_and_b32 v90, s40, v7
    s_and_b64 exec, vcc, s[50:51]
    s_cbranch_execz L_pf_3
    buffer_load_dword v127, v90, s[16:19], 0 offen
L_pf_3:
    s_mov_b64 exec, -1
    v_lshrrev_b32 v32, 26, v1
    v_lshrrev_b32 v33, 26, v3
    v_lshrrev_b32 v34, 26, v5
    v_lshrrev_b32 v35, 26, v7
    v_lshrrev_b32 v36, 26, v9
    v_lshrrev_b32 v37, 26, v11
    v_lshrrev_b32 v38, 26, v13
    v_lshrrev_b32 v39, 26, v15
    v_lshrrev_b32 v40, 26, v17
    v_lshrrev_b32 v41, 26, v19
    v_lshrrev_b32 v42, 26, v21
    v_lshrrev_b32 v43, 26, v23
    v_lshrrev_b32 v44, 26, v25
    v_lshrrev_b32 v45, 26, v27
    v_lshrrev_b32 v46, 26, v29
    v_lshrrev_b32 v47, 26, v31
    v_lshl_add_u32 v32, v32, 2, s59
    v_lshl_add_u32 v33, v33, 2, s59
    v_lshl_add_u32 v34, v34, 2, s59
    v_lshl_add_u32 v35, v35, 2, s59
    v_lshl_add_u32 v36, v36, 2, s59
    v_lshl_add_u32 v37, v37, 2, s59
    v_lshl_add_u32 v38, v38, 2, s59
    v_lshl_add_u32 v39, v39, 2, s59
    v_lshl_add_u32 v40, v40, 2, s59
    v_lshl_add_u32 v41, v41, 2, s59
    v_lshl_add_u32 v42, v42, 2, s59
    v_lshl_add_u32 v43, v43, 2, s59
    v_lshl_add_u32 v44, v44, 2, s59
    v_lshl_add_u32 v45, v45, 2, s59
    v_lshl_add_u32 v46, v46, 2, s59
    v_lshl_add_u32 v47, v47, 2, s59
    v_cmpx_lt_i32 vcc, 0, v68
    s_mov_b32 s58, 0
    s_cbranch_execz L_rank_done
    ds_add_rtn_u32 v48, v32, v71 offset:35328
    v_cmpx_lt_i32 vcc, 1, v68
    ds_add_rtn_u32 v49, v33, v71 offset:35328
    v_cmpx_lt_i32 vcc, 4, v68
    s_mov_b32 s58, 2
    s_cbranch_execz L_rank_done
    ds_add_rtn_u32 v50, v34, v71 offset:35328
    v_cmpx_lt_i32 vcc, 5, v68
    ds_add_rtn_u32 v51, v35, v71 offset:35328
    v_cmpx_lt_i32 vcc, 8, v68
    s_mov_b32 s58, 4
    s_cbranch_execz L_rank_done
    ds_add_rtn_u32 v52, v36, v71 offset:35328
    v_cmpx_lt_i32 vcc, 9, v68
    ds_add_rtn_u32 v53, v37, v71 offset:35328
    v_cmpx_lt_i32 vcc, 12, v68
    s_mov_b32 s58, 6
    s_cbranch_execz L_rank_done
    ds_add_rtn_u32 v54, v38, v71 offset:35328
    v_cmpx_lt_i32 vcc, 13, v68
    ds_add_rtn_u32 v55, v39, v71 offset:35328
    v_cmpx_lt_i32 vcc, 16, v68
    s_mov_b32 s58, 8
    s_cbranch_execz L_rank_done
    ds_add_rtn_u32 v56, v40, v71 offset:35328
    v_cmpx_lt_i32 vcc, 17, v68
    ds_add_rtn_u32 v57, v41, v71 offset:35328
    v_cmpx_lt_i32 vcc, 20, v68
    s_mov_b32 s58, 10
    s_cbranch_execz L_rank_done
    ds_add_rtn_u32 v58, v42, v71 offset:35328
    v_cmpx_lt_i32 vcc, 21, v68
    ds_add_rtn_u32 v59, v43, v71 offset:35328
    v_cmpx_lt_i32 vcc, 24, v68
    s_mov_b32 s58, 12
    s_cbranch_execz L_rank_done
    ds_add_rtn_u32 v60, v44, v71 offset:35328
    v_cmpx_lt_i32 vcc, 25, v68
    ds_add_rtn_u32 v61, v45, v71 offset:35328
    v_cmpx_lt_i32 vcc, 28, v68
    s_mov_b32 s58, 14
    s_cbranch_execz L_rank_done
    ds_add_rtn_u32 v62, v46, v71 offset:35328
    v_cmpx_lt_i32 vcc, 29, v68
    ds_add_rtn_u32 v63, v47, v71 offset:35328
    s_mov_b32 s58, 16
    v_cmpx_lt_i32 vcc, 32, v68
    ds_add_u32 v72, v71 offset:34816
L_rank_done:
    s_mov_b64 exec, -1
    ds_read_b32 v75, v87 offset:35328
    v_and_b32 v73, 0xe0, v69
    v_or_b32 v74, 28, v69
    v_and_b32 v83, 7, v67
    v_lshlrev_b32 v84, 5, v83
    v_lshrrev_b32 v86, 3, v67
    s_waitcnt lgkmcnt(0)
    ds_add_u32 v69, v75 offset:34816
    s_cmp_gt_u32 s3, 6
    s_cbranch_scc1 L_pw_done
    ds_add_u32 v87, v75 offset:37632
    s_cmp_gt_u32 s3, 5
    s_cbranch_scc1 L_pw_done
    ds_add_u32 v87, v75 offset:37888
    s_cmp_gt_u32 s3, 4
    s_cbranch_scc1 L_pw_done
    ds_add_u32 v87, v75 offset:38144
    s_cmp_gt_u32 s3, 3
    s_cbranch_scc1 L_pw_done
    ds_add_u32 v87, v75 offset:38400
    s_cmp_gt_u32 s3, 2
    s_cbranch_scc1 L_pw_done
    ds_add_u32 v87, v75 offset:38656
    s_cmp_gt_u32 s3, 1
    s_cbranch_scc1 L_pw_done
    ds_add_u32 v87, v75 offset:38912
    s_cmp_gt_u32 s3, 0
    s_cbranch_scc1 L_pw_done
    ds_add_u32 v87, v75 offset:39168
L_pw_done:
    s_waitcnt lgkmcnt(0)
    s_barrier
    ds_read_b32 v75, v69 offset:34816
    ds_read_b32 v76, v72 offset:34816
    ds_read_b32 v88, v87 offset:37376
    s_waitcnt lgkmcnt(2)
    v_mov_b32 v77, v75
    s_nop 1
    v_add_u32_dpp v77, v77, v77 row_shr:1 row_mask:0xf bank_mask:0xf
    s_nop 1
    v_add_u32_dpp v77, v77, v77 row_shr:2 row_mask:0xf bank_mask:0xf
    s_nop 1
    v_add_u32_dpp v77, v77, v77 row_shr:4 row_mask:0xf bank_mask:0xf
    s_nop 1
    v_add_u32_dpp v77, v77, v77 row_shr:8 row_mask:0xf bank_mask:0xf
    s_nop 1
    v_add_u32_dpp v77, v77, v77 row_bcast:15 row_mask:0xa bank_mask:0xf
    s_nop 1
    v_add_u32_dpp v77, v77, v77 row_bcast:31 row_mask:0xc bank_mask:0xf
    v_sub_u32 v78, v77, v75
    v_readlane_b32 s60, v77, 63
    ds_bpermute_b32 v79, v73, v78
    ds_bpermute_b32 v80, v74, v77
    v_cmp_eq_u32 vcc, v74, v69
    s_waitcnt lgkmcnt(0)
    v_readfirstlane_b32 s61, v76
    s_cmp_le_u32 s60, 3584
    s_cbranch_scc1 L_fits
    s_mov_b32 s34, s33
    s_mov_b32 s61, 0
    v_mov_b32 v68, 0
    v_mov_b32 v78, 0
    v_mov_b32 v79, 0
    v_mov_b32 v80, 0
L_fits:
    v_sub_u32 v80, v80, v79
    ds_bpermute_b32 v85, v84, v80
    v_add_u32 v81, 0x5f, v80
    v_and_b32 v81, 0xffe0, v81
    v_sub_u32 v81, v81, v80
    v_cndmask_b32 v81, 0, v81, vcc
    v_mov_b32 v82, v81
    s_nop 1
    v_add_u32_dpp v82, v82, v82 row_shr:1 row_mask:0xf bank_mask:0xf
    s_nop 1
    v_add_u32_dpp v82, v82, v82 row_shr:2 row_mask:0xf bank_mask:0xf
    s_nop 1
    v_add_u32_dpp v82, v82, v82 row_shr:4 row_mask:0xf bank_mask:0xf
    s_nop 1
    v_add_u32_dpp v82, v82, v82 row_shr:8 row_mask:0xf bank_mask:0xf
    s_nop 1
    v_add_u32_dpp v82, v82, v82 row_bcast:15 row_mask:0xa bank_mask:0xf
    s_nop 1
    v_add_u32_dpp v82, v82, v82 row_bcast:31 row_mask:0xc bank_mask:0xf
    v_sub_u32 v82, v82, v81
    v_add_lshl_u32 v78, v78, v82, 3
    v_lshl_add_u32 v86, v80, 3, v86
    v_lshl_add_u32 v88, v88, 3, v78
    s_waitcnt lgkmcnt(0)
    ds_bpermute_b32 v32, v32, v88
    ds_bpermute_b32 v33, v33, v88
    ds_bpermute_b32 v34, v34, v88
    ds_bpermute_b32 v35, v35, v88
    ds_bpermute_b32 v36, v36, v88
    ds_bpermute_b32 v37, v37, v88
    ds_bpermute_b32 v38, v38, v88
    ds_bpermute_b32 v39, v39, v88
    s_cmp_le_u32 s58, 8
    s_cbranch_scc1 L_lk_done
    ds_bpermute_b32 v40, v40, v88
    ds_bpermute_b32 v41, v41, v88
    s_cmp_le_u32 s58, 10
    s_cbranch_scc1 L_lk_done
    ds_bpermute_b32 v42, v42, v88
    ds_bpermute_b32 v43, v43, v88
    s_cmp_le_u32 s58, 12
    s_cbranch_scc1 L_lk_done
    ds_bpermute_b32 v44, v44, v88
    ds_bpermute_b32 v45, v45, v88
    s_cmp_le_u32 s58, 14
    s_cbranch_scc1 L_lk_done
    ds_bpermute_b32 v46, v46, v88
    ds_bpermute_b32 v47, v47, v88
L_lk_done:
    s_cmp_eq_u32 s47, 0
    s_cbranch_scc1 L_paired
    v_lshl_add_u32 v85, v85, 3, v83
    v_cmp_gt_u32 vcc, v85, v86
    s_sub_u32 s64, 11, s3
    s_cmp_lt_u32 s3, 4
    s_cselect_b32 s64, s3, s64
    s_mov_b32 s41, 0
    s_bfe_u32 s65, vcc_lo, 524288
    s_bcnt1_i32_b32 s65, s65
    s_cmp_eq_u32 s65, s64
    s_cselect_b32 s41, 0, s41
    s_bfe_u32 s65, vcc_lo, 524296
    s_bcnt1_i32_b32 s65, s65
    s_cmp_eq_u32 s65, s64
    s_cselect_b32 s41, 1, s41
    s_bfe_u32 s65, vcc_lo, 524304
    s_bcnt1_i32_b32 s65, s65
    s_cmp_eq_u32 s65, s64
    s_cselect_b32 s41, 2, s41
    s_bfe_u32 s65, vcc_lo, 524312
    s_bcnt1_i32_b32 s65, s65
    s_cmp_eq_u32 s65, s64
    s_cselect_b32 s41, 3, s41
    s_bfe_u32 s65, vcc_hi, 524288
    s_bcnt1_i32_b32 s65, s65
    s_cmp_eq_u32 s65, s64
    s_cselect_b32 s41, 4, s41
    s_bfe_u32 s65, vcc_hi, 524296
    s_bcnt1_i32_b32 s65, s65
    s_cmp_eq_u32 s65, s64
    s_cselect_b32 s41, 5, s41
    s_bfe_u32 s65, vcc_hi, 524304
    s_bcnt1_i32_b32 s65, s65
    s_cmp_eq_u32 s65, s64
    s_cselect_b32 s41, 6, s41
    s_bfe_u32 s65, vcc_hi, 524312
    s_bcnt1_i32_b32 s65, s65
    s_cmp_eq_u32 s65, s64
    s_cselect_b32 s41, 7, s41
L_paired:
    s_lshl_b32 s46, s41, 3
    v_readlane_b32 s62, v78, s46
    v_readlane_b32 s63, v80, s46
    s_waitcnt lgkmcnt(0)
    v_cmpx_lt_i32 vcc, 0, v68
    v_lshl_add_u32 v32, v48, 3, v32
    s_cbranch_execz L_scat_done
    ds_write_b64 v32, v[0:1]
    v_cmpx_lt_i32 vcc, 1, v68
    v_lshl_add_u32 v33, v49, 3, v33
    ds_write_b64 v33, v[2:3]
    v_cmpx_lt_i32 vcc, 4, v68
    v_lshl_add_u32 v34, v50, 3, v34
    s_cbranch_execz L_scat_done
    ds_write_b64 v34, v[4:5]
    v_cmpx_lt_i32 vcc, 5, v68
    v_lshl_add_u32 v35, v51, 3, v35
    ds_write_b64 v35, v[6:7]
    v_cmpx_lt_i32 vcc, 8, v68
    v_lshl_add_u32 v36, v52, 3, v36
    s_cbranch_execz L_scat_done
    ds_write_b64 v36, v[8:9]
    v_cmpx_lt_i32 vcc, 9, v68
    v_lshl_add_u32 v37, v53, 3, v37
    ds_write_b64 v37, v[10:11]
    v_cmpx_lt_i32 vcc, 12, v68
    v_lshl_add_u32 v38, v54, 3, v38
    s_cbranch_execz L_scat_done
    ds_write_b64 v38, v[12:13]
    v_cmpx_lt_i32 vcc, 13, v68
    v_lshl_add_u32 v39, v55, 3, v39
    ds_write_b64 v39, v[14:15]
    v_cmpx_lt_i32 vcc, 16, v68
    v_lshl_add_u32 v40, v56, 3, v40
    s_cbranch_execz L_scat_done
    ds_write_b64 v40, v[16:17]
    v_cmpx_lt_i32 vcc, 17, v68
    v_lshl_add_u32 v41, v57, 3, v41
    ds_write_b64 v41, v[18:19]
    v_cmpx_lt_i32 vcc, 20, v68
    v_lshl_add_u32 v42, v58, 3, v42
    s_cbranch_execz L_scat_done
    ds_write_b64 v42, v[20:21]
    v_cmpx_lt_i32 vcc, 21, v68
    v_lshl_add_u32 v43, v59, 3, v43
    ds_write_b64 v43, v[22:23]
    v_cmpx_lt_i32 vcc, 24, v68
    v_lshl_add_u32 v44, v60, 3, v44
    s_cbranch_execz L_scat_done
    ds_write_b64 v44, v[24:25]
    v_cmpx_lt_i32 vcc, 25, v68
    v_lshl_add_u32 v45, v61, 3, v45
    ds_write_b64 v45, v[26:27]
    v_cmpx_lt_i32 vcc, 28, v68
    v_lshl_add_u32 v46, v62, 3, v46
    s_cbranch_execz L_scat_done
    ds_write_b64 v46, v[28:29]
    v_cmpx_lt_i32 vcc, 29, v68
    v_lshl_add_u32 v47, v63, 3, v47
    ds_write_b64 v47, v[30:31]
L_scat_done:
    s_mov_b64 exec, -1
    s_cmp_eq_u32 s47, 0
    s_cbranch_scc1 L_nowin
    v_mov_b32 v80, 0
    v_mov_b32 v81, 0
    v_mov_b32 v82, 0
    v_mov_b32 v83, 0
    v_mov_b32 v84, 0
    v_mov_b32 v85, 0
    v_mov_b32 v86, 0
    v_mov_b32 v87, 0
    v_mov_b32 v88, 0
    v_mov_b32 v89, 0
    v_mov_b32 v90, 0
    v_mov_b32 v91, 0
    v_mov_b32 v92, 0
    v_mov_b32 v93, 0
    v_mov_b32 v94, 0
    v_mov_b32 v95, 0
    v_and_b32 v72, 31, v67
    v_lshl_add_u32 v72, v72, 7, v117
    s_lshl_b32 s46, s32, 3
    s_add_u32 s46, s46, s41
    s_mul_i32 s46, s46, 3125
    s_add_u32 s49, s46, 127
    s_lshr_b32 s49, s49, 7
    s_add_u32 s44, s46, 3252
    s_lshr_b32 s44, s44, 7
    s_sub_u32 s44, s44, s49
    s_lshl_b32 s49, s49, 7
    s_bfm_b32 s46, s44, 0
    s_mov_b32 exec_lo, s46
    s_mov_b32 exec_hi, s46
    buffer_load_dwordx4 v[80:83], v72, s[12:15], s49 offen offset:0
    buffer_load_dwordx4 v[84:87], v72, s[12:15], s49 offen offset:32
    buffer_load_dwordx4 v[88:91], v72, s[12:15], s49 offen offset:64
    buffer_load_dwordx4 v[92:95], v72, s[12:15], s49 offen offset:96
    s_mov_b64 exec, -1
L_nowin:
    s_add_u32 s64, s63, 31
    s_lshr_b32 s35, s64, 5
    s_lshl_b32 s64, s35, 5
    s_sub_u32 s64, s64, s63
    s_lshl_b32 s65, s63, 3
    s_add_u32 s65, s65, s62
    v_lshl_add_u32 v72, v67, 3, s65
    v_mov_b32 v74, 0xffffff00
    v_mov_b32 v75, 33554400
    ds_write_b64 v72, v[74:75]
    v_cmp_gt_u32 vcc, s64, v67
    s_and_saveexec_b64 s[50:51], vcc
    ds_write_b64 v72, v[74:75] offset:512
    s_mov_b64 exec, -1
    v_lshrrev_b32 v72, 3, v67
    v_lshl_add_u32 v118, v72, 5, s62
    v_and_b32 v72, 7, v67
    v_bfe_u32 v73, v67, 3, 2
    v_lshl_add_u32 v72, v72, 2, v73
    v_lshl_add_u32 v119, v72, 3, s62
    s_waitcnt lgkmcnt(0)
    s_barrier
    ds_read2_b32 v[104:105], v118 offset0:0 offset1:2
    ds_read2_b32 v[106:107], v118 offset0:4 offset1:6
    ds_read2_b32 v[108:109], v119 offset0:1 offset1:65
    s_waitcnt lgkmcnt(0)
    v_add_u32 v104, v116, v104
    v_xad_u32 v105, v116, 64, v105
    v_add_u32 v106, v116, v106
    v_xad_u32 v107, v116, 64, v107
    s_add_u32 m0, s37, 0
    s_nop 0
    buffer_load_dwordx4 v104, s[12:15], 0 offen lds
    s_add_u32 m0, s37, 1024
    s_nop 0
    buffer_load_dwordx4 v105, s[12:15], 0 offen lds
    s_add_u32 m0, s37, 2048
    s_nop 0
    buffer_load_dwordx4 v106, s[12:15], 0 offen lds
    s_add_u32 m0, s37, 3072
    s_nop 0
    buffer_load_dwordx4 v107, s[12:15], 0 offen lds
    v_and_or_b32 v110, v108, s40, v117
    buffer_load_dwordx4 v[96:99], v110, s[16:19], 0 offen
    ds_read2_b32 v[104:105], v118 offset0:64 offset1:66
    ds_read2_b32 v[106:107], v118 offset0:68 offset1:70
    s_cmp_eq_u32 s47, 0
    s_cbranch_scc1 L_noinit
    ds_read_b128 v[0:3], v70 offset:0
    ds_read_b128 v[4:7], v70 offset:1024
    ds_read_b128 v[8:11], v70 offset:2048
    ds_read_b128 v[12:15], v70 offset:3072
    ds_read_b128 v[16:19], v70 offset:4096
    ds_read_b128 v[20:23], v70 offset:5120
    ds_read_b128 v[24:27], v70 offset:6144
    ds_read_b128 v[28:31], v70 offset:7168
    s_waitcnt vmcnt(5) lgkmcnt(0)
    v_mfma_f32_32x32x16_bf16 v[32:47], v[80:83], v[0:3], 0
    v_mfma_f32_32x32x16_bf16 v[32:47], v[84:87], v[8:11], v[32:47]
    v_mfma_f32_32x32x16_bf16 v[32:47], v[88:91], v[16:19], v[32:47]
    v_mfma_f32_32x32x16_bf16 v[32:47], v[92:95], v[24:27], v[32:47]
    v_mfma_f32_32x32x16_bf16 v[48:63], v[80:83], v[4:7], 0
    v_mfma_f32_32x32x16_bf16 v[48:63], v[84:87], v[12:15], v[48:63]
    v_mfma_f32_32x32x16_bf16 v[48:63], v[88:91], v[20:23], v[48:63]
    v_mfma_f32_32x32x16_bf16 v[48:63], v[92:95], v[28:31], v[48:63]
    ds_read_b128 v[0:3], v70 offset:26624
    ds_read_b128 v[4:7], v70 offset:27648
    ds_read_b128 v[8:11], v70 offset:28672
    ds_read_b128 v[12:15], v70 offset:29696
    ds_read_b128 v[16:19], v70 offset:30720
    ds_read_b128 v[20:23], v70 offset:31744
    ds_read_b128 v[24:27], v70 offset:32768
    ds_read_b128 v[28:31], v70 offset:33792
    s_nop 7
    v_mul_f32 v32, s43, v32
    v_mul_f32 v33, s43, v33
    v_mul_f32 v34, s43, v34
    v_mul_f32 v35, s43, v35
    v_mul_f32 v36, s43, v36
    v_mul_f32 v37, s43, v37
    v_mul_f32 v38, s43, v38
    v_mul_f32 v39, s43, v39
    v_mul_f32 v40, s43, v40
    v_mul_f32 v41, s43, v41
    v_mul_f32 v42, s43, v42
    v_mul_f32 v43, s43, v43
    v_mul_f32 v44, s43, v44
    v_mul_f32 v45, s43, v45
    v_mul_f32 v46, s43, v46
    v_mul_f32 v47, s43, v47
    v_mul_f32 v48, s43, v48
    v_mul_f32 v49, s43, v49
    v_mul_f32 v50, s43, v50
    v_mul_f32 v51, s43, v51
    v_mul_f32 v52, s43, v52
    v_mul_f32 v53, s43, v53
    v_mul_f32 v54, s43, v54
    v_mul_f32 v55, s43, v55
    v_mul_f32 v56, s43, v56
    v_mul_f32 v57, s43, v57
    v_mul_f32 v58, s43, v58
    v_mul_f32 v59, s43, v59
    v_mul_f32 v60, s43, v60
    v_mul_f32 v61, s43, v61
    v_mul_f32 v62, s43, v62
    v_mul_f32 v63, s43, v63
    s_waitcnt lgkmcnt(0)
    ds_read_b128 a[0:3], v70 offset:8192
    ds_read_b128 a[4:7], v70 offset:9216
    ds_read_b128 a[8:11], v70 offset:10240
    ds_read_b128 a[12:15], v70 offset:11264
    ds_read_b128 a[16:19], v70 offset:12288
    ds_read_b128 a[20:23], v70 offset:13312
    ds_read_b128 a[24:27], v70 offset:14336
    ds_read_b128 a[28:31], v70 offset:15360
    ds_read_b128 a[32:35], v70 offset:16384
    ds_read_b128 a[36:39], v70 offset:17408
    ds_read_b128 a[40:43], v70 offset:18432
    ds_read_b128 a[44:47], v70 offset:19456
    ds_read_b128 a[48:51], v70 offset:20480
    ds_read_b128 a[52:55], v70 offset:21504
    ds_read_b128 a[56:59], v70 offset:22528
    ds_read_b128 a[60:63], v70 offset:23552
    ds_read_b128 a[64:67], v70 offset:24576
    ds_read_b128 a[68:71], v70 offset:25600
    v_mfma_f32_32x32x16_bf16 a[88:103], v[80:83], v[0:3], 0
    v_cvt_pk_bf16_f32 v64, v32, v33
    v_cvt_pk_bf16_f32 v65, v34, v35
    v_mfma_f32_32x32x16_bf16 a[88:103], v[84:87], v[8:11], a[88:103]
    v_cvt_pk_bf16_f32 v66, v36, v37
    v_cvt_pk_bf16_f32 v67, v38, v39
    v_mfma_f32_32x32x16_bf16 a[88:103], v[88:91], v[16:19], a[88:103]
    v_cvt_pk_bf16_f32 v68, v40, v41
    v_cvt_pk_bf16_f32 v69, v42, v43
    v_mfma_f32_32x32x16_bf16 a[88:103], v[92:95], v[24:27], a[88:103]
    v_cvt_pk_bf16_f32 v70, v44, v45
    v_cvt_pk_bf16_f32 v71, v46, v47
    v_mfma_f32_32x32x16_bf16 a[104:119], v[80:83], v[4:7], 0
    v_cvt_pk_bf16_f32 v72, v48, v49
    v_cvt_pk_bf16_f32 v73, v50, v51
    v_mfma_f32_32x32x16_bf16 a[104:119], v[84:87], v[12:15], a[104:119]
    v_cvt_pk_bf16_f32 v74, v52, v53
    v_cvt_pk_bf16_f32 v75, v54, v55
    v_mfma_f32_32x32x16_bf16 a[104:119], v[88:91], v[20:23], a[104:119]
    v_cvt_pk_bf16_f32 v76, v56, v57
    v_cvt_pk_bf16_f32 v77, v58, v59
    v_mfma_f32_32x32x16_bf16 a[104:119], v[92:95], v[28:31], a[104:119]
    v_cvt_pk_bf16_f32 v78, v60, v61
    v_cvt_pk_bf16_f32 v79, v62, v63
    v_accvgpr_write_b32 a72, v64
    v_accvgpr_write_b32 a73, v65
    v_accvgpr_write_b32 a74, v66
    v_accvgpr_write_b32 a75, v67
    v_accvgpr_write_b32 a80, v68
    v_accvgpr_write_b32 a81, v69
    v_accvgpr_write_b32 a82, v70
    v_accvgpr_write_b32 a83, v71
    v_accvgpr_write_b32 a76, v72
    v_accvgpr_write_b32 a77, v73
    v_accvgpr_write_b32 a78, v74
    v_accvgpr_write_b32 a79, v75
    v_accvgpr_write_b32 a84, v76
    v_accvgpr_write_b32 a85, v77
    v_accvgpr_write_b32 a86, v78
    v_accvgpr_write_b32 a87, v79
    s_mov_b32 s47, 0
L_noinit:
    s_cmp_eq_u32 s35, 0
    s_cbranch_scc1 L_round_end
    v_and_b32 v108, 31, v108
    v_mad_u32_u24 v111, v108, s42, v122
    v_mad_u32_u24 v123, v108, s42, v120
    ds_write_b16_d16_hi v123, v124
    s_waitcnt lgkmcnt(0)
    v_add_u32 v104, v116, v104
    v_xad_u32 v105, v116, 64, v105
    v_add_u32 v106, v116, v106
    v_xad_u32 v107, v116, 64, v107
    s_add_u32 m0, s37, 4096
    s_nop 0
    buffer_load_dwordx4 v104, s[12:15], 0 offen lds
    s_add_u32 m0, s37, 5120
    s_nop 0
    buffer_load_dwordx4 v105, s[12:15], 0 offen lds
    s_add_u32 m0, s37, 6144
    s_nop 0
    buffer_load_dwordx4 v106, s[12:15], 0 offen lds
    s_add_u32 m0, s37, 7168
    s_nop 0
    buffer_load_dwordx4 v107, s[12:15], 0 offen lds
    v_and_or_b32 v110, v109, s40, v117
    buffer_load_dwordx4 v[100:103], v110, s[16:19], 0 offen
    v_mov_b32 v32, 0
    v_mov_b32 v33, 0
    v_mov_b32 v34, 0
    v_mov_b32 v35, 0
    v_mov_b32 v36, 0
    v_mov_b32 v37, 0
    v_mov_b32 v38, 0
    v_mov_b32 v39, 0
    v_mov_b32 v88, 0
    v_mov_b32 v89, 0
    v_mov_b32 v90, 0
    v_mov_b32 v91, 0
    v_mov_b32 v92, 0
    v_mov_b32 v93, 0
    v_mov_b32 v94, 0
    v_mov_b32 v95, 0
    s_waitcnt vmcnt(5)
    ds_read_b128 v[80:83], v111 offset:0
    ds_read_b128 v[84:87], v111 offset:16
    ds_read_b128 v[64:67], v112 offset:0
    ds_read_b128 v[68:71], v113 offset:0
    ds_read_b128 v[72:75], v114 offset:0
    ds_read_b128 v[76:79], v115 offset:0
    ds_read2_b32 v[104:105], v118 offset0:128 offset1:130
    ds_read2_b32 v[106:107], v118 offset0:132 offset1:134
    s_mov_b32 s36, s35
    s_lshl_b32 s46, s3, 2
    s_add_u32 s46, s46, 35200
    v_mov_b32 v125, s46
    v_xor_b32 v126, 16, v125
    s_cmp_lt_u32 s3, 4
    s_cbranch_scc1 L_yp
    s_setprio 1
L_yp:
    v_mfma_f32_32x32x16_bf16 v[0:15], v[96:99], a[32:35], 0
    s_waitcnt lgkmcnt(0)
    v_mfma_f32_32x32x16_bf16 v[0:15], v[80:83], a[72:75], v[0:15]
    v_add_u32 v104, v116, v104
    v_xad_u32 v105, v116, 64, v105
    v_add_u32 v106, v116, v106
    v_xad_u32 v107, v116, 64, v107
    s_add_u32 m0, s37, 0
    s_nop 0
    buffer_load_dwordx4 v104, s[12:15], 0 offen lds
    s_add_u32 m0, s37, 1024
    s_nop 0
    buffer_load_dwordx4 v105, s[12:15], 0 offen lds
    s_add_u32 m0, s37, 2048
    s_nop 0
    buffer_load_dwordx4 v106, s[12:15], 0 offen lds
    s_add_u32 m0, s37, 3072
    s_nop 0
    buffer_load_dwordx4 v107, s[12:15], 0 offen lds
    v_mfma_f32_32x32x16_bf16 v[0:15], v[84:87], a[80:83], v[0:15]
    v_mfma_f32_32x32x16_bf16 v[0:15], v[64:67], a[0:3], v[0:15]
    v_mfma_f32_32x32x16_bf16 v[0:15], v[68:71], a[8:11], v[0:15]
    v_mfma_f32_32x32x16_bf16 v[0:15], v[72:75], a[16:19], v[0:15]
    v_mfma_f32_32x32x16_bf16 v[0:15], v[76:79], a[24:27], v[0:15]
    v_mfma_f32_32x32x16_bf16 v[16:31], v[64:67], a[40:43], 0
    v_mfma_f32_32x32x16_bf16 v[16:31], v[68:71], a[48:51], v[16:31]
    v_mfma_f32_32x32x16_bf16 v[16:31], v[72:75], a[56:59], v[16:31]
    v_mfma_f32_32x32x16_bf16 v[16:31], v[76:79], a[64:67], v[16:31]
    s_nop 7
    s_branch L_p1_0
L_loop:
    v_exp_f32 v32, v32
    v_exp_f32 v33, v33
    v_mfma_f32_32x32x16_bf16 a[88:103], v[88:91], v[0:3], a[88:103]
    v_exp_f32 v34, v34
    v_add_f32 v32, 1.0, v32
    v_exp_f32 v35, v35
    v_add_f32 v33, 1.0, v33
    v_exp_f32 v36, v36
    v_mfma_f32_32x32x16_bf16 a[88:103], v[92:95], v[4:7], a[88:103]
    v_add_f32 v34, 1.0, v34
    v_rcp_f32 v32, v32
    v_exp_f32 v37, v37
    v_add_f32 v35, 1.0, v35
    v_rcp_f32 v33, v33
    v_mfma_f32_32x32x16_bf16 v[0:15], v[96:99], a[32:35], 0
    v_exp_f32 v38, v38
    v_add_f32 v36, 1.0, v36
    v_rcp_f32 v34, v34
    v_mul_f32 v32, v32, v48
    v_exp_f32 v39, v39
    s_waitcnt lgkmcnt(2)
    v_mfma_f32_32x32x16_bf16 v[0:15], v[80:83], a[72:75], v[0:15]
    v_add_f32 v37, 1.0, v37
    v_rcp_f32 v35, v35
    v_mul_f32 v33, v33, v49
    v_exp_f32 v40, v40
    v_add_f32 v38, 1.0, v38
    v_mfma_f32_32x32x16_bf16 v[0:15], v[84:87], a[80:83], v[0:15]
    s_waitcnt lgkmcnt(0)
    v_rcp_f32 v36, v36
    v_add_u32 v104, v116, v104
    v_mul_f32 v34, v34, v50
    v_xad_u32 v105, v116, 64, v105
    v_exp_f32 v41, v41
    v_add_u32 v106, v116, v106
    v_add_f32 v39, 1.0, v39
    v_xad_u32 v107, v116, 64, v107
    v_rcp_f32 v37, v37
    s_add_u32 m0, s37, 0
    v_mul_f32 v35, v35, v51
    buffer_load_dwordx4 v104, s[12:15], 0 offen lds
    v_mfma_f32_32x32x16_bf16 v[0:15], v[64:67], a[0:3], v[0:15]
    v_cvt_pk_bf16_f32 v32, v32, v33
    s_add_u32 m0, s37, 1024
    v_exp_f32 v42, v42
    buffer_load_dwordx4 v105, s[12:15], 0 offen lds
    v_add_f32 v40, 1.0, v40
    s_add_u32 m0, s37, 2048
    v_rcp_f32 v38, v38
    buffer_load_dwordx4 v106, s[12:15], 0 offen lds
    v_mul_f32 v36, v36, v52
    s_add_u32 m0, s37, 3072
    v_mfma_f32_32x32x16_bf16 v[0:15], v[68:71], a[8:11], v[0:15]
    v_exp_f32 v43, v43
    buffer_load_dwordx4 v107, s[12:15], 0 offen lds
    v_add_f32 v41, 1.0, v41
    v_rcp_f32 v39, v39
    v_mul_f32 v37, v37, v53
    v_cvt_pk_bf16_f32 v33, v34, v35
    v_mfma_f32_32x32x16_bf16 v[0:15], v[72:75], a[16:19], v[0:15]
    v_exp_f32 v44, v44
    v_add_f32 v42, 1.0, v42
    v_rcp_f32 v40, v40
    v_mul_f32 v38, v38, v54
    v_exp_f32 v45, v45
    v_mfma_f32_32x32x16_bf16 v[0:15], v[76:79], a[24:27], v[0:15]
    v_add_f32 v43, 1.0, v43
    v_rcp_f32 v41, v41
    v_mul_f32 v39, v39, v55
    v_cvt_pk_bf16_f32 v34, v36, v37
    v_exp_f32 v46, v46
    v_add_f32 v44, 1.0, v44
    v_mfma_f32_32x32x16_bf16 v[16:31], v[64:67], a[40:43], 0
    v_rcp_f32 v42, v42
    v_mul_f32 v40, v40, v56
    v_exp_f32 v47, v47
    v_add_f32 v45, 1.0, v45
    v_rcp_f32 v43, v43
    v_mfma_f32_32x32x16_bf16 v[16:31], v[68:71], a[48:51], v[16:31]
    v_mul_f32 v41, v41, v57
    v_cvt_pk_bf16_f32 v35, v38, v39
    v_add_f32 v46, 1.0, v46
    v_rcp_f32 v44, v44
    v_mul_f32 v42, v42, v58
    v_mfma_f32_32x32x16_bf16 v[16:31], v[72:75], a[56:59], v[16:31]
    v_add_f32 v47, 1.0, v47
    v_rcp_f32 v45, v45
    v_mul_f32 v43, v43, v59
    v_cvt_pk_bf16_f32 v36, v40, v41
    v_rcp_f32 v46, v46
    v_mfma_f32_32x32x16_bf16 v[16:31], v[76:79], a[64:67], v[16:31]
    v_mul_f32 v44, v44, v60
    v_rcp_f32 v47, v47
    v_mul_f32 v45, v45, v61
    v_cvt_pk_bf16_f32 v37, v42, v43
    v_mul_f32 v46, v46, v62
    v_mul_f32 v47, v47, v63
    v_cvt_pk_bf16_f32 v38, v44, v45
    v_cvt_pk_bf16_f32 v39, v46, v47
L_p1_0:
    v_exp_f32 v0, v0
    v_exp_f32 v1, v1
    v_mfma_f32_32x32x16_bf16 a[104:119], v[88:91], v[32:35], a[104:119]
    ds_read2_b32 v[108:109], v119 offset0:65 offset1:129
    v_exp_f32 v2, v2
    v_add_f32 v0, 1.0, v0
    v_exp_f32 v3, v3
    v_add_f32 v1, 1.0, v1
    v_exp_f32 v4, v4
    v_mfma_f32_32x32x16_bf16 a[104:119], v[92:95], v[36:39], a[104:119]
    v_add_f32 v2, 1.0, v2
    ds_read_b128 v[88:91], v121
    v_rcp_f32 v0, v0
    ds_read_b128 v[92:95], v121 offset:32
    v_exp_f32 v5, v5
    ds_write_b16 v123, v124
    v_add_f32 v3, 1.0, v3
    v_rcp_f32 v1, v1
    v_mfma_f32_32x32x16_bf16 v[32:47], v[96:99], a[36:39], 0
    v_exp_f32 v6, v6
    v_add_f32 v4, 1.0, v4
    v_rcp_f32 v2, v2
    v_mul_f32 v0, v0, v16
    v_exp_f32 v7, v7
    v_mfma_f32_32x32x16_bf16 v[32:47], v[80:83], a[76:79], v[32:47]
    s_waitcnt lgkmcnt(3)
    v_and_or_b32 v110, v109, s40, v117
    buffer_load_dwordx4 v[96:99], v110, s[16:19], 0 offen
    v_add_f32 v5, 1.0, v5
    v_and_b32 v108, 31, v108
    v_rcp_f32 v3, v3
    v_add_u32 v118, 256, v118
    v_mul_f32 v1, v1, v17
    v_mad_u32_u24 v111, v108, s42, v122
    v_exp_f32 v8, v8
    v_mad_u32_u24 v123, v108, s42, v120
    v_add_f32 v6, 1.0, v6
    v_add_u32 v119, 256, v119
    v_mfma_f32_32x32x16_bf16 v[32:47], v[84:87], a[84:87], v[32:47]
    v_rcp_f32 v4, v4
    ds_write_b16_d16_hi v123, v124
    v_mul_f32 v2, v2, v18
    s_sub_u32 s36, s36, 1
    v_exp_f32 v9, v9
    v_add_f32 v7, 1.0, v7
    v_rcp_f32 v5, v5
    v_mul_f32 v3, v3, v19
    v_mfma_f32_32x32x16_bf16 v[32:47], v[64:67], a[4:7], v[32:47]
    v_cvt_pk_bf16_f32 v0, v0, v1
    v_exp_f32 v10, v10
    v_add_f32 v8, 1.0, v8
    v_rcp_f32 v6, v6
    v_mul_f32 v4, v4, v20
    v_mfma_f32_32x32x16_bf16 v[32:47], v[68:71], a[12:15], v[32:47]
    v_exp_f32 v11, v11
    v_mov_b32 v127, s36
    v_add_f32 v9, 1.0, v9
    ds_write_b32 v125, v127
    v_rcp_f32 v7, v7
    ds_read_b32 v110, v126
    v_mul_f32 v5, v5, v21
    v_cvt_pk_bf16_f32 v1, v2, v3
    v_mfma_f32_32x32x16_bf16 v[32:47], v[72:75], a[20:23], v[32:47]
    v_exp_f32 v12, v12
    v_add_f32 v10, 1.0, v10
    v_rcp_f32 v8, v8
    v_mul_f32 v6, v6, v22
    v_exp_f32 v13, v13
    v_mfma_f32_32x32x16_bf16 v[32:47], v[76:79], a[28:31], v[32:47]
    v_add_f32 v11, 1.0, v11
    v_rcp_f32 v9, v9
    v_mul_f32 v7, v7, v23
    v_cvt_pk_bf16_f32 v2, v4, v5
    v_exp_f32 v14, v14
    v_add_f32 v12, 1.0, v12
    v_mfma_f32_32x32x16_bf16 v[48:63], v[64:67], a[44:47], 0
    v_rcp_f32 v10, v10
    v_mul_f32 v8, v8, v24
    v_exp_f32 v15, v15
    v_add_f32 v13, 1.0, v13
    v_rcp_f32 v11, v11
    v_mfma_f32_32x32x16_bf16 v[48:63], v[68:71], a[52:55], v[48:63]
    v_mul_f32 v9, v9, v25
    v_cvt_pk_bf16_f32 v3, v6, v7
    v_add_f32 v14, 1.0, v14
    v_rcp_f32 v12, v12
    v_mul_f32 v10, v10, v26
    v_mfma_f32_32x32x16_bf16 v[48:63], v[72:75], a[60:63], v[48:63]
    v_add_f32 v15, 1.0, v15
    v_rcp_f32 v13, v13
    v_mul_f32 v11, v11, v27
    v_cvt_pk_bf16_f32 v4, v8, v9
    v_rcp_f32 v14, v14
    v_mfma_f32_32x32x16_bf16 v[48:63], v[76:79], a[68:71], v[48:63]
    s_waitcnt vmcnt(5) lgkmcnt(0)
    ds_read_b128 v[80:83], v111 offset:0
    ds_read_b128 v[84:87], v111 offset:16
    ds_read_b128 v[64:67], v112 offset:4096
    ds_read_b128 v[68:71], v113 offset:4096
    ds_read_b128 v[72:75], v114 offset:4096
    ds_read_b128 v[76:79], v115 offset:4096
    ds_read2_b32 v[104:105], v118 offset0:128 offset1:130
    ds_read2_b32 v[106:107], v118 offset0:132 offset1:134
    v_readfirstlane_b32 s46, v110
    s_setprio 0
    s_cmp_lt_u32 s36, s46
    s_cbranch_scc1 L_sy_0
    s_setprio 1
L_sy_0:
    v_mul_f32 v12, v12, v28
    v_rcp_f32 v15, v15
    v_mul_f32 v13, v13, v29
    v_cvt_pk_bf16_f32 v5, v10, v11
    v_mul_f32 v14, v14, v30
    v_mul_f32 v15, v15, v31
    v_cvt_pk_bf16_f32 v6, v12, v13
    v_cvt_pk_bf16_f32 v7, v14, v15
    s_cmp_eq_u32 s36, 0
    s_cbranch_scc1 L_tail
    v_exp_f32 v32, v32
    v_exp_f32 v33, v33
    v_mfma_f32_32x32x16_bf16 a[88:103], v[88:91], v[0:3], a[88:103]
    v_exp_f32 v34, v34
    v_add_f32 v32, 1.0, v32
    v_exp_f32 v35, v35
    v_add_f32 v33, 1.0, v33
    v_exp_f32 v36, v36
    v_mfma_f32_32x32x16_bf16 a[88:103], v[92:95], v[4:7], a[88:103]
    v_add_f32 v34, 1.0, v34
    v_rcp_f32 v32, v32
    v_exp_f32 v37, v37
    v_add_f32 v35, 1.0, v35
    v_rcp_f32 v33, v33
    v_mfma_f32_32x32x16_bf16 v[0:15], v[100:103], a[32:35], 0
    v_exp_f32 v38, v38
    v_add_f32 v36, 1.0, v36
    v_rcp_f32 v34, v34
    v_mul_f32 v32, v32, v48
    v_exp_f32 v39, v39
    s_waitcnt lgkmcnt(2)
    v_mfma_f32_32x32x16_bf16 v[0:15], v[80:83], a[72:75], v[0:15]
    v_add_f32 v37, 1.0, v37
    v_rcp_f32 v35, v35
    v_mul_f32 v33, v33, v49
    v_exp_f32 v40, v40
    v_add_f32 v38, 1.0, v38
    v_mfma_f32_32x32x16_bf16 v[0:15], v[84:87], a[80:83], v[0:15]
    s_waitcnt lgkmcnt(0)
    v_rcp_f32 v36, v36
    v_add_u32 v104, v116, v104
    v_mul_f32 v34, v34, v50
    v_xad_u32 v105, v116, 64, v105
    v_exp_f32 v41, v41
    v_add_u32 v106, v116, v106
    v_add_f32 v39, 1.0, v39
    v_xad_u32 v107, v116, 64, v107
    v_rcp_f32 v37, v37
    s_add_u32 m0, s37, 4096
    v_mul_f32 v35, v35, v51
    buffer_load_dwordx4 v104, s[12:15], 0 offen lds
    v_mfma_f32_32x32x16_bf16 v[0:15], v[64:67], a[0:3], v[0:15]
    v_cvt_pk_bf16_f32 v32, v32, v33
    s_add_u32 m0, s37, 5120
    v_exp_f32 v42, v42
    buffer_load_dwordx4 v105, s[12:15], 0 offen lds
    v_add_f32 v40, 1.0, v40
    s_add_u32 m0, s37, 6144
    v_rcp_f32 v38, v38
    buffer_load_dwordx4 v106, s[12:15], 0 offen lds
    v_mul_f32 v36, v36, v52
    s_add_u32 m0, s37, 7168
    v_mfma_f32_32x32x16_bf16 v[0:15], v[68:71], a[8:11], v[0:15]
    v_exp_f32 v43, v43
    buffer_load_dwordx4 v107, s[12:15], 0 offen lds
    v_add_f32 v41, 1.0, v41
    v_rcp_f32 v39, v39
    v_mul_f32 v37, v37, v53
    v_cvt_pk_bf16_f32 v33, v34, v35
    v_mfma_f32_32x32x16_bf16 v[0:15], v[72:75], a[16:19], v[0:15]
    v_exp_f32 v44, v44
    v_add_f32 v42, 1.0, v42
    v_rcp_f32 v40, v40
    v_mul_f32 v38, v38, v54
    v_exp_f32 v45, v45
    v_mfma_f32_32x32x16_bf16 v[0:15], v[76:79], a[24:27], v[0:15]
    v_add_f32 v43, 1.0, v43
    v_rcp_f32 v41, v41
    v_mul_f32 v39, v39, v55
    v_cvt_pk_bf16_f32 v34, v36, v37
    v_exp_f32 v46, v46
    v_add_f32 v44, 1.0, v44
    v_mfma_f32_32x32x16_bf16 v[16:31], v[64:67], a[40:43], 0
    v_rcp_f32 v42, v42
    v_mul_f32 v40, v40, v56
    v_exp_f32 v47, v47
    v_add_f32 v45, 1.0, v45
    v_rcp_f32 v43, v43
    v_mfma_f32_32x32x16_bf16 v[16:31], v[68:71], a[48:51], v[16:31]
    v_mul_f32 v41, v41, v57
    v_cvt_pk_bf16_f32 v35, v38, v39
    v_add_f32 v46, 1.0, v46
    v_rcp_f32 v44, v44
    v_mul_f32 v42, v42, v58
    v_mfma_f32_32x32x16_bf16 v[16:31], v[72:75], a[56:59], v[16:31]
    v_add_f32 v47, 1.0, v47
    v_rcp_f32 v45, v45
    v_mul_f32 v43, v43, v59
    v_cvt_pk_bf16_f32 v36, v40, v41
    v_rcp_f32 v46, v46
    v_mfma_f32_32x32x16_bf16 v[16:31], v[76:79], a[64:67], v[16:31]
    v_mul_f32 v44, v44, v60
    v_rcp_f32 v47, v47
    v_mul_f32 v45, v45, v61
    v_cvt_pk_bf16_f32 v37, v42, v43
    v_mul_f32 v46, v46, v62
    v_mul_f32 v47, v47, v63
    v_cvt_pk_bf16_f32 v38, v44, v45
    v_cvt_pk_bf16_f32 v39, v46, v47
L_p1_1:
    v_exp_f32 v0, v0
    v_exp_f32 v1, v1
    v_mfma_f32_32x32x16_bf16 a[104:119], v[88:91], v[32:35], a[104:119]
    ds_read2_b32 v[108:109], v119 offset0:65 offset1:129
    v_exp_f32 v2, v2
    v_add_f32 v0, 1.0, v0
    v_exp_f32 v3, v3
    v_add_f32 v1, 1.0, v1
    v_exp_f32 v4, v4
    v_mfma_f32_32x32x16_bf16 a[104:119], v[92:95], v[36:39], a[104:119]
    v_add_f32 v2, 1.0, v2
    ds_read_b128 v[88:91], v121
    v_rcp_f32 v0, v0
    ds_read_b128 v[92:95], v121 offset:32
    v_exp_f32 v5, v5
    ds_write_b16 v123, v124
    v_add_f32 v3, 1.0, v3
    v_rcp_f32 v1, v1
    v_mfma_f32_32x32x16_bf16 v[32:47], v[100:103], a[36:39], 0
    v_exp_f32 v6, v6
    v_add_f32 v4, 1.0, v4
    v_rcp_f32 v2, v2
    v_mul_f32 v0, v0, v16
    v_exp_f32 v7, v7
    v_mfma_f32_32x32x16_bf16 v[32:47], v[80:83], a[76:79], v[32:47]
    s_waitcnt lgkmcnt(3)
    v_and_or_b32 v110, v109, s40, v117
    buffer_load_dwordx4 v[100:103], v110, s[16:19], 0 offen
    v_add_f32 v5, 1.0, v5
    v_and_b32 v108, 31, v108
    v_rcp_f32 v3, v3
    v_add_u32 v118, 256, v118
    v_mul_f32 v1, v1, v17
    v_mad_u32_u24 v111, v108, s42, v122
    v_exp_f32 v8, v8
    v_mad_u32_u24 v123, v108, s42, v120
    v_add_f32 v6, 1.0, v6
    v_add_u32 v119, 256, v119
    v_mfma_f32_32x32x16_bf16 v[32:47], v[84:87], a[84:87], v[32:47]
    v_rcp_f32 v4, v4
    ds_write_b16_d16_hi v123, v124
    v_mul_f32 v2, v2, v18
    s_sub_u32 s36, s36, 1
    v_exp_f32 v9, v9
    v_add_f32 v7, 1.0, v7
    v_rcp_f32 v5, v5
    v_mul_f32 v3, v3, v19
    v_mfma_f32_32x32x16_bf16 v[32:47], v[64:67], a[4:7], v[32:47]
    v_cvt_pk_bf16_f32 v0, v0, v1
    v_exp_f32 v10, v10
    v_add_f32 v8, 1.0, v8
    v_rcp_f32 v6, v6
    v_mul_f32 v4, v4, v20
    v_mfma_f32_32x32x16_bf16 v[32:47], v[68:71], a[12:15], v[32:47]
    v_exp_f32 v11, v11
    v_mov_b32 v127, s36
    v_add_f32 v9, 1.0, v9
    ds_write_b32 v125, v127
    v_rcp_f32 v7, v7
    ds_read_b32 v110, v126
    v_mul_f32 v5, v5, v21
    v_cvt_pk_bf16_f32 v1, v2, v3
    v_mfma_f32_32x32x16_bf16 v[32:47], v[72:75], a[20:23], v[32:47]
    v_exp_f32 v12, v12
    v_add_f32 v10, 1.0, v10
    v_rcp_f32 v8, v8
    v_mul_f32 v6, v6, v22
    v_exp_f32 v13, v13
    v_mfma_f32_32x32x16_bf16 v[32:47], v[76:79], a[28:31], v[32:47]
    v_add_f32 v11, 1.0, v11
    v_rcp_f32 v9, v9
    v_mul_f32 v7, v7, v23
    v_cvt_pk_bf16_f32 v2, v4, v5
    v_exp_f32 v14, v14
    v_add_f32 v12, 1.0, v12
    v_mfma_f32_32x32x16_bf16 v[48:63], v[64:67], a[44:47], 0
    v_rcp_f32 v10, v10
    v_mul_f32 v8, v8, v24
    v_exp_f32 v15, v15
    v_add_f32 v13, 1.0, v13
    v_rcp_f32 v11, v11
    v_mfma_f32_32x32x16_bf16 v[48:63], v[68:71], a[52:55], v[48:63]
    v_mul_f32 v9, v9, v25
    v_cvt_pk_bf16_f32 v3, v6, v7
    v_add_f32 v14, 1.0, v14
    v_rcp_f32 v12, v12
    v_mul_f32 v10, v10, v26
    v_mfma_f32_32x32x16_bf16 v[48:63], v[72:75], a[60:63], v[48:63]
    v_add_f32 v15, 1.0, v15
    v_rcp_f32 v13, v13
    v_mul_f32 v11, v11, v27
    v_cvt_pk_bf16_f32 v4, v8, v9
    v_rcp_f32 v14, v14
    v_mfma_f32_32x32x16_bf16 v[48:63], v[76:79], a[68:71], v[48:63]
    s_waitcnt vmcnt(5) lgkmcnt(0)
    ds_read_b128 v[80:83], v111 offset:0
    ds_read_b128 v[84:87], v111 offset:16
    ds_read_b128 v[64:67], v112 offset:0
    ds_read_b128 v[68:71], v113 offset:0
    ds_read_b128 v[72:75], v114 offset:0
    ds_read_b128 v[76:79], v115 offset:0
    ds_read2_b32 v[104:105], v118 offset0:128 offset1:130
    ds_read2_b32 v[106:107], v118 offset0:132 offset1:134
    v_readfirstlane_b32 s46, v110
    s_setprio 0
    s_cmp_lt_u32 s36, s46
    s_cbranch_scc1 L_sy_1
    s_setprio 1
L_sy_1:
    v_mul_f32 v12, v12, v28
    v_rcp_f32 v15, v15
    v_mul_f32 v13, v13, v29
    v_cvt_pk_bf16_f32 v5, v10, v11
    v_mul_f32 v14, v14, v30
    v_mul_f32 v15, v15, v31
    v_cvt_pk_bf16_f32 v6, v12, v13
    v_cvt_pk_bf16_f32 v7, v14, v15
    s_cmp_eq_u32 s36, 0
    s_cbranch_scc0 L_loop
L_tail:
    ds_write_b16 v123, v124
    s_nop 0
    v_mfma_f32_32x32x16_bf16 a[88:103], v[88:91], v[0:3], a[88:103]
    v_mfma_f32_32x32x16_bf16 a[88:103], v[92:95], v[4:7], a[88:103]
    v_exp_f32 v32, v32
    v_exp_f32 v33, v33
    v_exp_f32 v34, v34
    v_add_f32 v32, 1.0, v32
    v_exp_f32 v35, v35
    v_add_f32 v33, 1.0, v33
    v_exp_f32 v36, v36
    v_add_f32 v34, 1.0, v34
    v_rcp_f32 v32, v32
    v_exp_f32 v37, v37
    v_add_f32 v35, 1.0, v35
    v_rcp_f32 v33, v33
    v_exp_f32 v38, v38
    v_add_f32 v36, 1.0, v36
    v_rcp_f32 v34, v34
    v_mul_f32 v32, v32, v48
    v_exp_f32 v39, v39
    v_add_f32 v37, 1.0, v37
    v_rcp_f32 v35, v35
    v_mul_f32 v33, v33, v49
    v_exp_f32 v40, v40
    v_add_f32 v38, 1.0, v38
    v_rcp_f32 v36, v36
    v_mul_f32 v34, v34, v50
    v_exp_f32 v41, v41
    v_add_f32 v39, 1.0, v39
    v_rcp_f32 v37, v37
    v_mul_f32 v35, v35, v51
    v_cvt_pk_bf16_f32 v32, v32, v33
    v_exp_f32 v42, v42
    v_add_f32 v40, 1.0, v40
    v_rcp_f32 v38, v38
    v_mul_f32 v36, v36, v52
    v_exp_f32 v43, v43
    v_add_f32 v41, 1.0, v41
    v_rcp_f32 v39, v39
    v_mul_f32 v37, v37, v53
    v_cvt_pk_bf16_f32 v33, v34, v35
    v_exp_f32 v44, v44
    v_add_f32 v42, 1.0, v42
    v_rcp_f32 v40, v40
    v_mul_f32 v38, v38, v54
    v_exp_f32 v45, v45
    v_add_f32 v43, 1.0, v43
    v_rcp_f32 v41, v41
    v_mul_f32 v39, v39, v55
    v_cvt_pk_bf16_f32 v34, v36, v37
    v_exp_f32 v46, v46
    v_add_f32 v44, 1.0, v44
    v_rcp_f32 v42, v42
    v_mul_f32 v40, v40, v56
    v_exp_f32 v47, v47
    v_add_f32 v45, 1.0, v45
    v_rcp_f32 v43, v43
    v_mul_f32 v41, v41, v57
    v_cvt_pk_bf16_f32 v35, v38, v39
    v_add_f32 v46, 1.0, v46
    v_rcp_f32 v44, v44
    v_mul_f32 v42, v42, v58
    v_add_f32 v47, 1.0, v47
    v_rcp_f32 v45, v45
    v_mul_f32 v43, v43, v59
    v_cvt_pk_bf16_f32 v36, v40, v41
    v_rcp_f32 v46, v46
    v_mul_f32 v44, v44, v60
    v_rcp_f32 v47, v47
    v_mul_f32 v45, v45, v61
    v_cvt_pk_bf16_f32 v37, v42, v43
    v_mul_f32 v46, v46, v62
    v_mul_f32 v47, v47, v63
    v_cvt_pk_bf16_f32 v38, v44, v45
    v_cvt_pk_bf16_f32 v39, v46, v47
    s_nop 1
    v_mfma_f32_32x32x16_bf16 a[104:119], v[88:91], v[32:35], a[104:119]
    v_mfma_f32_32x32x16_bf16 a[104:119], v[92:95], v[36:39], a[104:119]
L_round_end:
    s_add_u32 s45, s45, 32
    s_cmp_lg_u32 s61, 0
    s_cbranch_scc1 L_next
    s_cmp_ge_u32 s34, 250
    s_cbranch_scc1 L_epi
    s_mov_b32 s33, s34
    s_add_u32 s34, s34, 100
    s_min_u32 s34, s34, 250
    s_mov_b32 s45, 0
L_next:
    v_mbcnt_lo_u32_b32 v67, -1, 0
    v_mbcnt_hi_u32_b32 v67, -1, v67
    s_waitcnt vmcnt(0) lgkmcnt(0)
    s_barrier
    s_branch L_round
L_epi:
    s_waitcnt vmcnt(0) lgkmcnt(0)
    s_mov_b32 s28, s8
    s_mov_b32 s29, s9
    s_mov_b32 s30, 6400000
    s_mov_b32 s31, 0x00020000
    v_mbcnt_lo_u32_b32 v67, -1, 0
    v_mbcnt_hi_u32_b32 v67, -1, v67
    v_and_b32 v68, 31, v67
    v_lshrrev_b32 v69, 5, v67
    v_lshlrev_b32 v68, 2, v68
    v_lshl_add_u32 v68, v69, 9, v68
    v_add_u32 v68, s37, v68
    v_lshlrev_b32 v70, 4, v67
    v_add_u32 v71, s37, v70
    s_nop 7
    v_accvgpr_read_b32 v0, a88
    v_accvgpr_read_b32 v1, a89
    v_accvgpr_read_b32 v2, a90
    v_accvgpr_read_b32 v3, a91
    v_accvgpr_read_b32 v4, a92
    v_accvgpr_read_b32 v5, a93
    v_accvgpr_read_b32 v6, a94
    v_accvgpr_read_b32 v7, a95
    v_accvgpr_read_b32 v8, a96
    v_accvgpr_read_b32 v9, a97
    v_accvgpr_read_b32 v10, a98
    v_accvgpr_read_b32 v11, a99
    v_accvgpr_read_b32 v12, a100
    v_accvgpr_read_b32 v16, a104
    v_accvgpr_read_b32 v17, a105
    v_accvgpr_read_b32 v18, a106
    v_accvgpr_read_b32 v19, a107
    v_accvgpr_read_b32 v20, a108
    v_accvgpr_read_b32 v21, a109
    v_accvgpr_read_b32 v22, a110
    v_accvgpr_read_b32 v23, a111
    v_accvgpr_read_b32 v24, a112
    v_accvgpr_read_b32 v25, a113
    v_accvgpr_read_b32 v26, a114
    v_accvgpr_read_b32 v27, a115
    v_accvgpr_read_b32 v28, a116
    v_mul_f32 v32, s43, v0
    v_mul_f32 v33, s43, v1
    v_mul_f32 v34, s43, v2
    v_mul_f32 v35, s43, v3
    v_mul_f32 v36, s43, v4
    v_mul_f32 v37, s43, v5
    v_mul_f32 v38, s43, v6
    v_mul_f32 v39, s43, v7
    v_mul_f32 v40, s43, v8
    v_mul_f32 v41, s43, v9
    v_mul_f32 v42, s43, v10
    v_mul_f32 v43, s43, v11
    v_mul_f32 v44, s43, v12
    v_mul_f32 v48, s43, v16
    v_mul_f32 v49, s43, v17
    v_mul_f32 v50, s43, v18
    v_mul_f32 v51, s43, v19
    v_mul_f32 v52, s43, v20
    v_mul_f32 v53, s43, v21
    v_mul_f32 v54, s43, v22
    v_mul_f32 v55, s43, v23
    v_mul_f32 v56, s43, v24
    v_mul_f32 v57, s43, v25
    v_mul_f32 v58, s43, v26
    v_mul_f32 v59, s43, v27
    v_mul_f32 v60, s43, v28
    v_exp_f32 v32, v32
    v_exp_f32 v33, v33
    v_exp_f32 v34, v34
    v_exp_f32 v35, v35
    v_exp_f32 v36, v36
    v_exp_f32 v37, v37
    v_exp_f32 v38, v38
    v_exp_f32 v39, v39
    v_exp_f32 v40, v40
    v_exp_f32 v41, v41
    v_exp_f32 v42, v42
    v_exp_f32 v43, v43
    v_exp_f32 v44, v44
    v_exp_f32 v48, v48
    v_exp_f32 v49, v49
    v_exp_f32 v50, v50
    v_exp_f32 v51, v51
    v_exp_f32 v52, v52
    v_exp_f32 v53, v53
    v_exp_f32 v54, v54
    v_exp_f32 v55, v55
    v_exp_f32 v56, v56
    v_exp_f32 v57, v57
    v_exp_f32 v58, v58
    v_exp_f32 v59, v59
    v_exp_f32 v60, v60
    v_add_f32 v32, 1.0, v32
    v_add_f32 v33, 1.0, v33
    v_add_f32 v34, 1.0, v34
    v_add_f32 v35, 1.0, v35
    v_add_f32 v36, 1.0, v36
    v_add_f32 v37, 1.0, v37
    v_add_f32 v38, 1.0, v38
    v_add_f32 v39, 1.0, v39
    v_add_f32 v40, 1.0, v40
    v_add_f32 v41, 1.0, v41
    v_add_f32 v42, 1.0, v42
    v_add_f32 v43, 1.0, v43
    v_add_f32 v44, 1.0, v44
    v_add_f32 v48, 1.0, v48
    v_add_f32 v49, 1.0, v49
    v_add_f32 v50, 1.0, v50
    v_add_f32 v51, 1.0, v51
    v_add_f32 v52, 1.0, v52
    v_add_f32 v53, 1.0, v53
    v_add_f32 v54, 1.0, v54
    v_add_f32 v55, 1.0, v55
    v_add_f32 v56, 1.0, v56
    v_add_f32 v57, 1.0, v57
    v_add_f32 v58, 1.0, v58
    v_add_f32 v59, 1.0, v59
    v_add_f32 v60, 1.0, v60
    v_rcp_f32 v32, v32
    v_rcp_f32 v33, v33
    v_rcp_f32 v34, v34
    v_rcp_f32 v35, v35
    v_rcp_f32 v36, v36
    v_rcp_f32 v37, v37
    v_rcp_f32 v38, v38
    v_rcp_f32 v39, v39
    v_rcp_f32 v40, v40
    v_rcp_f32 v41, v41
    v_rcp_f32 v42, v42
    v_rcp_f32 v43, v43
    v_rcp_f32 v44, v44
    v_rcp_f32 v48, v48
    v_rcp_f32 v49, v49
    v_rcp_f32 v50, v50
    v_rcp_f32 v51, v51
    v_rcp_f32 v52, v52
    v_rcp_f32 v53, v53
    v_rcp_f32 v54, v54
    v_rcp_f32 v55, v55
    v_rcp_f32 v56, v56
    v_rcp_f32 v57, v57
    v_rcp_f32 v58, v58
    v_rcp_f32 v59, v59
    v_rcp_f32 v60, v60
    v_mul_f32 v0, v0, v32
    v_mul_f32 v1, v1, v33
    v_mul_f32 v2, v2, v34
    v_mul_f32 v3, v3, v35
    v_mul_f32 v4, v4, v36
    v_mul_f32 v5, v5, v37
    v_mul_f32 v6, v6, v38
    v_mul_f32 v7, v7, v39
    v_mul_f32 v8, v8, v40
    v_mul_f32 v9, v9, v41
    v_mul_f32 v10, v10, v42
    v_mul_f32 v11, v11, v43
    v_mul_f32 v12, v12, v44
    v_mul_f32 v16, v16, v48
    v_mul_f32 v17, v17, v49
    v_mul_f32 v18, v18, v50
    v_mul_f32 v19, v19, v51
    v_mul_f32 v20, v20, v52
    v_mul_f32 v21, v21, v53
    v_mul_f32 v22, v22, v54
    v_mul_f32 v23, v23, v55
    v_mul_f32 v24, v24, v56
    v_mul_f32 v25, v25, v57
    v_mul_f32 v26, v26, v58
    v_mul_f32 v27, v27, v59
    v_mul_f32 v28, v28, v60
    v_cvt_pk_bf16_f32 v32, v0, v16
    v_cvt_pk_bf16_f32 v33, v1, v17
    v_cvt_pk_bf16_f32 v34, v2, v18
    v_cvt_pk_bf16_f32 v35, v3, v19
    v_cvt_pk_bf16_f32 v36, v4, v20
    v_cvt_pk_bf16_f32 v37, v5, v21
    v_cvt_pk_bf16_f32 v38, v6, v22
    v_cvt_pk_bf16_f32 v39, v7, v23
    v_cvt_pk_bf16_f32 v40, v8, v24
    v_cvt_pk_bf16_f32 v41, v9, v25
    v_cvt_pk_bf16_f32 v42, v10, v26
    v_cvt_pk_bf16_f32 v43, v11, v27
    v_cvt_pk_bf16_f32 v44, v12, v28
    ds_write_b32 v68, v32 offset:0
    ds_write_b32 v68, v33 offset:128
    ds_write_b32 v68, v34 offset:256
    ds_write_b32 v68, v35 offset:384
    ds_write_b32 v68, v36 offset:1024
    ds_write_b32 v68, v37 offset:1152
    ds_write_b32 v68, v38 offset:1280
    ds_write_b32 v68, v39 offset:1408
    ds_write_b32 v68, v40 offset:2048
    ds_write_b32 v68, v41 offset:2176
    ds_write_b32 v68, v42 offset:2304
    ds_write_b32 v68, v43 offset:2432
    ds_write_b32 v68, v44 offset:3072
    s_waitcnt lgkmcnt(0)
    ds_read_b128 v[0:3], v71 offset:0
    ds_read_b128 v[4:7], v71 offset:1024
    ds_read_b128 v[8:11], v71 offset:2048
    ds_read_b128 v[12:15], v71 offset:3072
    s_waitcnt lgkmcnt(3)
    buffer_store_dwordx4 v[0:3], v70, s[28:31], s49 offen offset:0 sc1
    s_waitcnt lgkmcnt(2)
    buffer_store_dwordx4 v[4:7], v70, s[28:31], s49 offen offset:1024 sc1
    s_waitcnt lgkmcnt(1)
    buffer_store_dwordx4 v[8:11], v70, s[28:31], s49 offen offset:2048 sc1
    s_cmp_lt_u32 s44, 25
    s_cbranch_scc1 L_k2_fin
    s_waitcnt lgkmcnt(0)
    s_mov_b64 exec, 0xff
    buffer_store_dwordx4 v[12:15], v70, s[28:31], s49 offen offset:3072 sc1
L_k2_fin:
L_k2_end:
    s_endpgm
.section .rodata,"a"
.p2align 6
.amdhsa_kernel egc_bin_kernel
  .amdhsa_next_free_vgpr 56
  .amdhsa_next_free_sgpr 72
  .amdhsa_accum_offset 56
  .amdhsa_group_segment_fixed_size 0
  .amdhsa_kernarg_size 80
  .amdhsa_user_sgpr_count 2
  .amdhsa_user_sgpr_kernarg_segment_ptr 1
  .amdhsa_system_sgpr_workgroup_id_x 1
.end_amdhsa_kernel
.p2align 6
.amdhsa_kernel egc_main_kernel
  .amdhsa_next_free_vgpr 248
  .amdhsa_next_free_sgpr 96
  .amdhsa_accum_offset 128
  .amdhsa_group_segment_fixed_size 0
  .amdhsa_kernarg_size 80
  .amdhsa_user_sgpr_count 2
  .amdhsa_user_sgpr_kernarg_segment_ptr 1
  .amdhsa_system_sgpr_workgroup_id_x 1
.end_amdhsa_kernel
```
